```python
import torch

def _softmax(x, axis=-1):
    return torch.softmax(x, dim=axis)

def _gelu(x):
    return torch.nn.functional.gelu(x, approximate='tanh')

def _silu(x):
    return torch.nn.functional.silu(x)

def _sigmoid(x):
    return torch.sigmoid(x)

def _layernorm(x, axis=-1, eps=1e-05):
    m = x.mean(dim=axis, keepdim=True)
    v = x.var(dim=axis, keepdim=True, unbiased=False)
    return (x - m) / torch.sqrt(v + eps)

def _scatter_add(tgt, idx, src, axis=0):
    return tgt.clone().index_add_(axis, idx, src)

def _segment_sum(src, seg, n):
    out = torch.zeros((n,) + src.shape[1:], dtype=src.dtype)
    return out.index_add_(0, seg, src)

def _pad(x, pw):
    flat = tuple((v for pair in reversed(pw) for v in pair))
    return torch.nn.functional.pad(x, flat)
kernel_name = 'standalone__tree_speculative_verify_tree_attention_over_candidate_token_tree__sampling'

def setup_inputs():

    _w = lambda a: (lambda t: t.to(torch.bfloat16) if t.is_floating_point() else t)(torch.as_tensor(a))
    B, Hq, Hkv, T, C, D = (8, 32, 32, 16, 4096, 128)
    tree_mask = torch.zeros((B, T, T), dtype=float)
    for b in range(B):
        parent = torch.zeros(T, dtype=torch.int64)
        for i in range(1, T):
            parent[i] = int(torch.randint(0, i, (1,)).item())
        for i in range(T):
            j = i
            tree_mask[b, i, j] = 1.0
            while j > 0:
                j = parent[j]
                tree_mask[b, i, j] = 1.0
    return {'q': _w((lambda *s: torch.randn(*s, dtype=torch.bfloat16) * 0.8)(B, Hq, T, D)), 'k_cache': _w((lambda *s: torch.randn(*s, dtype=torch.bfloat16) * 0.8)(B, Hkv, C, D)), 'v_cache': _w((lambda *s: torch.randn(*s, dtype=torch.bfloat16) * 0.05)(B, Hkv, C, D)), 'k_tree': _w((lambda *s: torch.randn(*s, dtype=torch.bfloat16) * 0.8)(B, Hkv, T, D)), 'v_tree': _w((lambda *s: torch.randn(*s, dtype=torch.bfloat16) * 0.05)(B, Hkv, T, D)), 'tree_mask': _w(tree_mask)}

def reference(q, k_cache, v_cache, k_tree, v_tree, tree_mask):
    B, Hq, T, D = q.shape
    Hkv, C = (k_cache.shape[1], k_cache.shape[2])
    rep = Hq // Hkv
    kc = (lambda x, n, axis: torch.repeat_interleave(x, n, dim=axis))(k_cache, rep, axis=1)
    vc = (lambda x, n, axis: torch.repeat_interleave(x, n, dim=axis))(v_cache, rep, axis=1)
    kt = (lambda x, n, axis: torch.repeat_interleave(x, n, dim=axis))(k_tree, rep, axis=1)
    vt = (lambda x, n, axis: torch.repeat_interleave(x, n, dim=axis))(v_tree, rep, axis=1)
    k = torch.concatenate([kc, kt], axis=2)
    v = torch.concatenate([vc, vt], axis=2)
    scale = D ** (-0.5)
    scores = torch.einsum('bhqd,bhkd->bhqk', q, k) * scale
    ctx_mask = torch.ones((B, 1, T, C), dtype=scores.dtype)
    tm = tree_mask[:, None, :, :].clone()
    full_mask = torch.concatenate([ctx_mask, tm], axis=-1)
    scores = scores + (1.0 - full_mask) * -1000000000.0
    p = _softmax(scores, axis=-1)
    return torch.einsum('bhqk,bhkd->bhqd', p, v)
```

```asm
; @launch grid=(256,1,1) block=(320,1,1) lds=153856
.amdgcn_target "amdgcn-amd-amdhsa--gfx950"
.text
.globl standalone__tree_speculative_verify_tree_attention_over_candidate_token_tree__sampling_kernel
.p2align 8
.type standalone__tree_speculative_verify_tree_attention_over_candidate_token_tree__sampling_kernel,@function
standalone__tree_speculative_verify_tree_attention_over_candidate_token_tree__sampling_kernel:
    s_load_dwordx16 s[4:19], s[0:1], 0
    s_load_dwordx2 s[26:27], s[0:1], 64
    v_lshrrev_b32 v6, 6, v0
    v_and_b32 v29, 15, v0
    v_readfirstlane_b32 s40, v6
    v_bfe_u32 v30, v0, 4, 2
    s_cmp_ge_u32 s2, 256
    s_cbranch_scc1 L_end
    v_lshlrev_b32 v6, 1, v30
    v_xor_b32 v6, v6, v29
    v_lshlrev_b32 v6, 4, v6
    v_lshl_add_u32 v1, v30, 8, v6
    s_lshr_b32 s3, s2, 4
    s_and_b32 s3, s3, 7
    s_xor_b32 s3, s3, s2
    s_lshl_b32 s47, s3, 20
    s_lshl_b32 s41, s40, 13
    s_lshl_b32 s48, s3, 12
    s_add_u32 s47, s47, s41
    s_sub_u32 s22, 0x100000, s41
    s_mul_i32 s50, s40, 9216
    s_mov_b32 s23, 0x00020000
    s_mov_b32 s41, 0
    s_mov_b32 s49, 32
    s_mov_b32 s30, 4096
    s_mov_b32 s31, 0x00020000
    s_add_u32 m0, s50, 0
    s_cmp_eq_u32 s40, 4
    s_waitcnt lgkmcnt(0)
    s_cbranch_scc1 L_tree0
L_go:
    s_add_u32 s20, s6, s47
    s_addc_u32 s21, s7, 0
    buffer_load_dwordx4 v1, s[20:23], s41 offen offset:0 nt lds
    s_add_u32 m0, s50, 256
    s_mov_b32 s45, s49
    buffer_load_dwordx4 v1, s[20:23], s41 offen offset:2048 nt lds
    s_add_u32 s28, s4, s48
    s_addc_u32 s29, s5, 0
    s_mul_i32 s51, s40, 1152
    s_add_u32 m0, s51, 47104
    s_lshl_b32 s51, s40, 10
    buffer_load_dwordx4 v1, s[28:31], s51 offen nt lds
    s_add_u32 m0, s50, 128
    s_nop 0
    buffer_load_dwordx4 v1, s[20:23], s41 offen offset:1024 nt lds
    s_add_u32 m0, s50, 384
    s_nop 0
    buffer_load_dwordx4 v1, s[20:23], s41 offen offset:3072 nt lds
    s_add_u32 s42, s41, 4096
    s_add_u32 m0, s50, 4608
    s_nop 0
    buffer_load_dwordx4 v1, s[20:23], s42 offen offset:0 nt lds
    s_add_u32 s24, s8, s47
    s_addc_u32 s25, s9, 0
    s_mul_i32 s51, s40, 9216
    v_lshrrev_b32 v6, 2, v29
    v_mul_u32_u24 v2, 1152, v6
    v_and_b32 v7, 3, v29
    v_lshl_add_u32 v2, v7, 8, v2
    v_lshlrev_b32 v7, 1, v7
    v_xor_b32 v7, v7, v30
    v_lshl_add_u32 v2, v7, 4, v2
    v_add_u32 v9, 47104, v2
    v_add_u32 v2, s51, v2
    v_xor_b32 v10, 64, v9
    v_xor_b32 v3, 64, v2
    s_mov_b32 s44, 0x3e0293ee
    v_mov_b32 v4, 0xff800000
    v_mov_b32 v5, 0
    s_mov_b32 s46, 0
    s_mov_b32 s43, s49
    s_mov_b64 vcc, 0
    s_add_u32 s32, s16, s48
    s_addc_u32 s33, s17, 0
    s_mov_b32 s34, 4096
    s_mov_b32 s35, 0x00020000
    s_mov_b32 s36, s18
    s_mov_b32 s37, s19
    s_mov_b32 s38, 36
    s_mov_b32 s39, 0x00020000
    s_lshr_b32 s47, s2, 3
    v_and_b32 v28, 63, v0
    v_lshl_add_u32 v31, v0, 6, s47
    v_mov_b32 v27, 1
    s_mul_i32 s54, s47, 3
    s_add_u32 s54, s54, 4
    s_cmp_lt_u32 s47, 19
    s_cselect_b32 s54, s54, 0
    s_cmp_eq_u32 s40, 1
    s_cselect_b32 s54, s54, 0
    s_mul_i32 s47, s47, 4352
    s_add_u32 s26, s26, s47
    s_addc_u32 s27, s27, 0
    s_add_u32 m0, s50, 4864
    s_waitcnt vmcnt(5)
    buffer_load_dwordx4 v1, s[20:23], s42 offen offset:2048 nt lds
    s_add_u32 m0, s50, 4736
    s_waitcnt vmcnt(5)
    buffer_load_dwordx4 v1, s[20:23], s42 offen offset:1024 nt lds
    s_add_u32 m0, s50, 4992
    s_waitcnt vmcnt(4)
    buffer_load_dwordx4 v1, s[20:23], s42 offen offset:3072 nt lds
    s_add_u32 s41, s41, 32768
    s_xor_b32 s50, s50, 65536
    s_sub_u32 s45, s45, 1
    s_cmp_eq_u32 s45, 0
    s_cselect_b64 s[20:21], s[24:25], s[20:21]
    s_cselect_b32 s41, 0, s41
    s_add_u32 m0, s50, 0
    s_waitcnt vmcnt(4)
    buffer_load_dwordx4 v1, s[20:23], s41 offen offset:0 nt lds
    s_cmp_eq_u32 s40, 4
    s_cbranch_scc1 L_nobar0
    v_mov_b32 v72, 0
    v_mov_b32 v73, 0
    v_mov_b32 v74, 0
    v_mov_b32 v75, 0
    v_mov_b32 v76, 0
    v_mov_b32 v77, 0
    v_mov_b32 v78, 0
    v_mov_b32 v79, 0
    s_barrier
L_nobar0:
    ds_read_b128 v[32:35], v9 offset:0
    ds_read_b128 v[36:39], v10 offset:0
    ds_read_b128 v[40:43], v9 offset:128
    ds_read_b128 v[44:47], v10 offset:128
L_p1:
    s_add_u32 m0, s50, 256
    s_cbranch_vccnz L_b1
    s_waitcnt vmcnt(3)
L_b1:
    s_waitcnt vmcnt(5)
    buffer_load_dwordx4 v1, s[20:23], s41 offen offset:2048 nt lds
    v_add_u32 v27, 1, v27
    buffer_store_byte v27, v31, s[36:39], 0 offen
    buffer_load_ubyte v26, v28, s[36:39], 0 offen nt
    ds_read_b128 v[48:51], v2 offset:0
    ds_read_b128 v[52:55], v3 offset:0
    ds_read_b128 v[56:59], v2 offset:128
    ds_read_b128 v[60:63], v3 offset:128
    s_add_u32 m0, s50, 128
    s_cbranch_vccnz L_b2
    s_waitcnt vmcnt(6)
L_b2:
    s_waitcnt vmcnt(7)
    buffer_load_dwordx4 v1, s[20:23], s41 offen offset:1024 nt lds
    s_waitcnt lgkmcnt(3)
    v_mfma_f32_16x16x32_bf16 v[64:67], v[48:51], v[32:35], v[72:75]
    s_waitcnt lgkmcnt(2)
    v_mfma_f32_16x16x32_bf16 v[64:67], v[52:55], v[36:39], v[64:67]
    s_waitcnt lgkmcnt(1)
    v_mfma_f32_16x16x32_bf16 v[64:67], v[56:59], v[40:43], v[64:67]
    s_waitcnt lgkmcnt(0)
    v_mfma_f32_16x16x32_bf16 v[64:67], v[60:63], v[44:47], v[64:67]
    s_add_u32 m0, s50, 384
    s_cbranch_vccnz L_b3
    s_waitcnt vmcnt(6)
L_b3:
    s_waitcnt vmcnt(7)
    buffer_load_dwordx4 v1, s[20:23], s41 offen offset:3072 nt lds
    s_add_u32 s42, s41, 4096
    s_sub_u32 s54, s54, 1
    s_cmp_eq_u32 s54, 0
    s_cbranch_scc1 L_gr0
L_grb0:
    s_add_u32 m0, s50, 4608
    s_cbranch_vccnz L_b4
    s_waitcnt vmcnt(6)
L_b4:
    s_waitcnt vmcnt(7)
    buffer_load_dwordx4 v1, s[20:23], s42 offen offset:0 nt lds
    s_cmp_eq_u32 s43, s49
    s_cbranch_scc1 L_once
L_onceb:
    s_add_u32 m0, s50, 4864
    s_cbranch_vccnz L_b5
    s_waitcnt vmcnt(6)
L_b5:
    s_waitcnt vmcnt(6)
    buffer_load_dwordx4 v1, s[20:23], s42 offen offset:2048 nt lds
    ds_read_b128 v[48:51], v2 offset:4608
    ds_read_b128 v[52:55], v3 offset:4608
    ds_read_b128 v[56:59], v2 offset:4736
    ds_read_b128 v[60:63], v3 offset:4736
    v_xor_b32 v2, 65536, v2
    v_xor_b32 v3, 65536, v3
    s_add_u32 m0, s50, 4736
    s_cbranch_vccnz L_b6
    s_waitcnt vmcnt(6)
L_b6:
    s_waitcnt vmcnt(7)
    buffer_load_dwordx4 v1, s[20:23], s42 offen offset:1024 nt lds
    s_waitcnt lgkmcnt(3)
    v_mfma_f32_16x16x32_bf16 v[68:71], v[48:51], v[32:35], v[76:79]
    s_waitcnt lgkmcnt(2)
    v_mfma_f32_16x16x32_bf16 v[68:71], v[52:55], v[36:39], v[68:71]
    s_waitcnt lgkmcnt(1)
    v_mfma_f32_16x16x32_bf16 v[68:71], v[56:59], v[40:43], v[68:71]
    s_waitcnt lgkmcnt(0)
    v_mfma_f32_16x16x32_bf16 v[68:71], v[60:63], v[44:47], v[68:71]
    s_add_u32 m0, s50, 4992
    s_cbranch_vccnz L_b7
    s_waitcnt vmcnt(4)
L_b7:
    s_waitcnt vmcnt(7)
    buffer_load_dwordx4 v1, s[20:23], s42 offen offset:3072 nt lds
    s_add_u32 s41, s41, 32768
    s_xor_b32 s50, s50, 65536
    s_sub_u32 s45, s45, 1
    s_cmp_eq_u32 s45, 0
    s_cselect_b64 s[20:21], s[24:25], s[20:21]
    s_cselect_b32 s41, 0, s41
    v_max3_f32 v6, v64, v65, v66
    v_max3_f32 v7, v67, v68, v69
    v_max3_f32 v6, v6, v70, v71
    v_max_f32 v6, v6, v7
    v_mov_b32 v7, v6
    s_nop 1
    v_permlane32_swap_b32 v6, v7
    v_max_f32 v6, v6, v7
    v_mov_b32 v7, v6
    s_nop 1
    v_permlane16_swap_b32 v6, v7
    v_max_f32 v6, v6, v7
    v_mul_f32 v6, s44, v6
    v_max_f32 v6, v6, v4
    v_sub_f32 v8, v4, v6
    v_mov_b32 v4, v6
    v_exp_f32 v8, v8
    s_add_u32 m0, s50, 0
    s_cbranch_vccnz L_b8
    s_waitcnt vmcnt(4)
L_b8:
    s_waitcnt vmcnt(5)
    buffer_load_dwordx4 v1, s[20:23], s41 offen offset:0 nt lds
    v_fma_f32 v64, v64, s44, -v4
    v_fma_f32 v65, v65, s44, -v4
    v_fma_f32 v66, v66, s44, -v4
    v_fma_f32 v67, v67, s44, -v4
    v_fma_f32 v68, v68, s44, -v4
    v_fma_f32 v69, v69, s44, -v4
    v_fma_f32 v70, v70, s44, -v4
    v_fma_f32 v71, v71, s44, -v4
    v_exp_f32 v64, v64
    v_exp_f32 v65, v65
    v_exp_f32 v66, v66
    v_exp_f32 v67, v67
    v_exp_f32 v68, v68
    v_exp_f32 v69, v69
    v_exp_f32 v70, v70
    v_exp_f32 v71, v71
    v_add_f32 v6, v64, v65
    v_add_f32 v7, v66, v67
    v_fma_f32 v5, v5, v8, v6
    v_add_f32 v6, v68, v69
    v_add_f32 v5, v5, v7
    v_add_f32 v7, v70, v71
    v_add_f32 v5, v5, v6
    v_cvt_pk_bf16_f32 v16, v64, v65
    v_cvt_pk_bf16_f32 v17, v66, v67
    v_cvt_pk_bf16_f32 v18, v68, v69
    v_cvt_pk_bf16_f32 v19, v70, v71
    v_add_f32 v5, v5, v7
    s_set_gpr_idx_on s46, gpr_idx(DST)
    v_mov_b32 v96, v16
    v_mov_b32 v97, v17
    v_mov_b32 v98, v18
    v_mov_b32 v99, v19
    v_mov_b32 v100, v8
    s_set_gpr_idx_off
    s_add_u32 s46, s46, 5
    v_cmp_ge_u32 vcc, v26, v27
    v_readlane_b32 s53, v26, 32
    s_bcnt1_i32_b32 s52, vcc_lo
    s_xor_b32 s53, s53, 20
    s_cmp_gt_u32 s52, s53
    s_cselect_b64 vcc, -1, 0
    s_sub_u32 s43, s43, 1
    s_cmp_lg_u32 s43, 0
    s_cbranch_scc1 L_p1
    v_mov_b32 v7, v5
    s_nop 1
    v_permlane32_swap_b32 v5, v7
    v_add_f32 v5, v5, v7
    v_mov_b32 v7, v5
    s_nop 1
    v_permlane16_swap_b32 v5, v7
    v_add_f32 v5, v5, v7
    ds_write_b64 v11, v[4:5]
    v_lshrrev_b32 v6, 4, v0
    v_lshlrev_b32 v6, 6, v6
    s_mov_b32 s46, 0
    s_mov_b32 s43, s49
    s_cmp_eq_u32 s40, 4
    s_cselect_b64 exec, 0, -1
    s_waitcnt lgkmcnt(0)
    s_cbranch_scc1 L_nobar1
    s_barrier
L_nobar1:
    ds_read_b128 v[64:67], v6 offset:46080
    ds_read_b128 v[68:71], v6 offset:46096
    ds_read_b64 v[72:73], v6 offset:46112
    ds_read_b128 v[80:83], v10 offset:33792
    ds_read_b128 v[84:87], v10 offset:33808
    s_waitcnt lgkmcnt(0)
    v_max3_f32 v6, v64, v66, v68
    v_max3_f32 v6, v6, v70, v72
    v_sub_f32 v20, v64, v6
    v_sub_f32 v21, v66, v6
    v_sub_f32 v22, v68, v6
    v_sub_f32 v23, v70, v6
    v_sub_f32 v24, v72, v6
    v_exp_f32 v20, v20
    v_exp_f32 v21, v21
    v_exp_f32 v22, v22
    v_exp_f32 v23, v23
    v_exp_f32 v24, v24
    s_nop 0
    v_mul_f32 v7, v20, v65
    v_fma_f32 v7, v21, v67, v7
    v_fma_f32 v7, v22, v69, v7
    v_fma_f32 v7, v23, v71, v7
    v_fma_f32 v7, v24, v73, v7
    v_rcp_f32 v7, v7
    s_nop 0
    v_mul_f32 v20, v20, v7
    v_mul_f32 v21, v21, v7
    v_mul_f32 v22, v22, v7
    v_mul_f32 v23, v23, v7
    v_mul_f32 v24, v24, v7
    v_mul_f32 v2, v80, v24
    v_mul_f32 v3, v81, v24
    v_mul_f32 v4, v82, v24
    v_mul_f32 v5, v83, v24
    v_mul_f32 v11, v84, v24
    v_mul_f32 v29, v86, v24
    v_mul_f32 v30, v87, v24
    v_mul_f32 v25, v85, v24
    s_mov_b64 exec, -1
L_p2:
    s_add_u32 m0, s50, 256
    s_cbranch_vccnz L_b9
    s_waitcnt vmcnt(3)
L_b9:
    s_waitcnt vmcnt(5)
    buffer_load_dwordx4 v1, s[20:23], s41 offen offset:2048 nt lds
    v_add_u32 v27, 1, v27
    buffer_store_byte v27, v31, s[36:39], 0 offen
    buffer_load_ubyte v26, v28, s[36:39], 0 offen nt
    ds_read_b64_tr_b16 v[64:65], v12 offset:0
    ds_read_b64_tr_b16 v[68:69], v13 offset:0
    ds_read_b64_tr_b16 v[72:73], v14 offset:0
    ds_read_b64_tr_b16 v[76:77], v15 offset:0
    ds_read_b64_tr_b16 v[80:81], v12 offset:128
    ds_read_b64_tr_b16 v[84:85], v13 offset:128
    ds_read_b64_tr_b16 v[88:89], v14 offset:128
    ds_read_b64_tr_b16 v[92:93], v15 offset:128
    s_add_u32 m0, s50, 128
    s_cbranch_vccnz L_b10
    s_waitcnt vmcnt(6)
L_b10:
    s_waitcnt vmcnt(7)
    buffer_load_dwordx4 v1, s[20:23], s41 offen offset:1024 nt lds
    s_set_gpr_idx_on s46, gpr_idx(SRC0)
    v_mov_b32 v16, v96
    v_mov_b32 v17, v97
    v_mov_b32 v18, v98
    v_mov_b32 v19, v99
    v_mov_b32 v8, v100
    s_set_gpr_idx_off
    s_add_u32 s46, s46, 5
    s_waitcnt lgkmcnt(0)
    s_add_u32 m0, s50, 384
    s_cbranch_vccnz L_b11
    s_waitcnt vmcnt(6)
L_b11:
    s_waitcnt vmcnt(7)
    buffer_load_dwordx4 v1, s[20:23], s41 offen offset:3072 nt lds
    s_add_u32 s42, s41, 4096
    v_mul_legacy_f32 v32, v32, v8
    v_mul_legacy_f32 v33, v33, v8
    v_mul_legacy_f32 v34, v34, v8
    v_mul_legacy_f32 v35, v35, v8
    v_mul_legacy_f32 v36, v36, v8
    v_mul_legacy_f32 v37, v37, v8
    v_mul_legacy_f32 v38, v38, v8
    v_mul_legacy_f32 v39, v39, v8
    v_mul_legacy_f32 v40, v40, v8
    v_mul_legacy_f32 v41, v41, v8
    v_mul_legacy_f32 v42, v42, v8
    v_mul_legacy_f32 v43, v43, v8
    v_mul_legacy_f32 v44, v44, v8
    v_mul_legacy_f32 v45, v45, v8
    v_mul_legacy_f32 v46, v46, v8
    v_mul_legacy_f32 v47, v47, v8
    s_add_u32 m0, s50, 4608
    s_cbranch_vccnz L_b12
    s_waitcnt vmcnt(6)
L_b12:
    s_waitcnt vmcnt(7)
    buffer_load_dwordx4 v1, s[20:23], s42 offen offset:0 nt lds
    v_mul_legacy_f32 v48, v48, v8
    v_mul_legacy_f32 v49, v49, v8
    v_mul_legacy_f32 v50, v50, v8
    v_mul_legacy_f32 v51, v51, v8
    v_mul_legacy_f32 v52, v52, v8
    v_mul_legacy_f32 v53, v53, v8
    v_mul_legacy_f32 v54, v54, v8
    v_mul_legacy_f32 v55, v55, v8
    v_mul_legacy_f32 v56, v56, v8
    v_mul_legacy_f32 v57, v57, v8
    v_mul_legacy_f32 v58, v58, v8
    v_mul_legacy_f32 v59, v59, v8
    v_mul_legacy_f32 v60, v60, v8
    v_mul_legacy_f32 v61, v61, v8
    v_mul_legacy_f32 v62, v62, v8
    v_mul_legacy_f32 v63, v63, v8
    s_add_u32 m0, s50, 4864
    s_sub_u32 s43, s43, 1
    s_cmp_eq_u32 s43, 0
    s_cbranch_vccnz L_b13
    s_waitcnt vmcnt(6)
L_b13:
    s_waitcnt vmcnt(6)
    ds_read_b64_tr_b16 v[66:67], v12 offset:4608
    ds_read_b64_tr_b16 v[70:71], v13 offset:4608
    ds_read_b64_tr_b16 v[74:75], v14 offset:4608
    ds_read_b64_tr_b16 v[78:79], v15 offset:4608
    ds_read_b64_tr_b16 v[82:83], v12 offset:4736
    ds_read_b64_tr_b16 v[86:87], v13 offset:4736
    ds_read_b64_tr_b16 v[90:91], v14 offset:4736
    ds_read_b64_tr_b16 v[94:95], v15 offset:4736
    v_xor_b32 v12, 65536, v12
    v_xor_b32 v13, 65536, v13
    v_xor_b32 v14, 65536, v14
    v_xor_b32 v15, 65536, v15
    s_cbranch_scc1 L_epi
    buffer_load_dwordx4 v1, s[20:23], s42 offen offset:2048 nt lds
    s_waitcnt lgkmcnt(7)
    v_mfma_f32_16x16x32_bf16 v[32:35], v[64:67], v[16:19], v[32:35]
    s_waitcnt lgkmcnt(6)
    v_mfma_f32_16x16x32_bf16 v[36:39], v[68:71], v[16:19], v[36:39]
    s_waitcnt lgkmcnt(5)
    v_mfma_f32_16x16x32_bf16 v[40:43], v[72:75], v[16:19], v[40:43]
    s_waitcnt lgkmcnt(4)
    v_mfma_f32_16x16x32_bf16 v[44:47], v[76:79], v[16:19], v[44:47]
    s_waitcnt lgkmcnt(3)
    v_mfma_f32_16x16x32_bf16 v[48:51], v[80:83], v[16:19], v[48:51]
    s_waitcnt lgkmcnt(2)
    v_mfma_f32_16x16x32_bf16 v[52:55], v[84:87], v[16:19], v[52:55]
    s_waitcnt lgkmcnt(1)
    v_mfma_f32_16x16x32_bf16 v[56:59], v[88:91], v[16:19], v[56:59]
    s_waitcnt lgkmcnt(0)
    v_mfma_f32_16x16x32_bf16 v[60:63], v[92:95], v[16:19], v[60:63]
    s_add_u32 m0, s50, 4736
    s_cbranch_vccnz L_b14
    s_waitcnt vmcnt(6)
L_b14:
    s_waitcnt vmcnt(7)
    buffer_load_dwordx4 v1, s[20:23], s42 offen offset:1024 nt lds
    s_sub_u32 s54, s54, 1
    s_cmp_eq_u32 s54, 0
    s_cbranch_scc1 L_gr1
L_grb1:
    s_add_u32 m0, s50, 4992
    s_cbranch_vccnz L_b15
    s_waitcnt vmcnt(4)
L_b15:
    s_waitcnt vmcnt(7)
    buffer_load_dwordx4 v1, s[20:23], s42 offen offset:3072 nt lds
    s_add_u32 s41, s41, 32768
    s_xor_b32 s50, s50, 65536
    s_add_u32 m0, s50, 0
    s_cbranch_vccnz L_b16
    s_waitcnt vmcnt(4)
L_b16:
    s_waitcnt vmcnt(5)
    buffer_load_dwordx4 v1, s[20:23], s41 offen offset:0 nt lds
    v_cmp_ge_u32 vcc, v26, v27
    v_readlane_b32 s53, v26, 32
    s_bcnt1_i32_b32 s52, vcc_lo
    s_xor_b32 s53, s53, 20
    s_cmp_gt_u32 s52, s53
    s_cselect_b64 vcc, -1, 0
    s_branch L_p2
L_epi:
    s_cmp_eq_u32 s40, 4
    v_lshlrev_b32 v6, 4, v0
    s_waitcnt lgkmcnt(7)
    v_mfma_f32_16x16x32_bf16 v[32:35], v[64:67], v[16:19], v[32:35]
    s_waitcnt lgkmcnt(6)
    v_mfma_f32_16x16x32_bf16 v[36:39], v[68:71], v[16:19], v[36:39]
    s_waitcnt lgkmcnt(5)
    v_mfma_f32_16x16x32_bf16 v[40:43], v[72:75], v[16:19], v[40:43]
    s_waitcnt lgkmcnt(4)
    v_mfma_f32_16x16x32_bf16 v[44:47], v[76:79], v[16:19], v[44:47]
    s_waitcnt lgkmcnt(3)
    v_mfma_f32_16x16x32_bf16 v[48:51], v[80:83], v[16:19], v[48:51]
    ds_write_b128 v9, v[32:35] offset:0
    s_waitcnt lgkmcnt(3)
    v_mfma_f32_16x16x32_bf16 v[52:55], v[84:87], v[16:19], v[52:55]
    ds_write_b128 v9, v[36:39] offset:64
    s_waitcnt lgkmcnt(3)
    v_mfma_f32_16x16x32_bf16 v[56:59], v[88:91], v[16:19], v[56:59]
    ds_write_b128 v9, v[40:43] offset:128
    s_waitcnt lgkmcnt(3)
    v_mfma_f32_16x16x32_bf16 v[60:63], v[92:95], v[16:19], v[60:63]
    ds_write_b128 v9, v[44:47] offset:192
    s_nop 0
    ds_write_b128 v9, v[48:51] offset:256
    s_nop 1
    ds_write_b128 v9, v[52:55] offset:320
    s_nop 1
    ds_write_b128 v9, v[56:59] offset:384
    s_nop 1
    ds_write_b128 v9, v[60:63] offset:448
    s_cselect_b64 exec, 0, -1
    s_waitcnt lgkmcnt(0)
    s_cbranch_scc1 L_nobar2
    s_barrier
L_nobar2:
    ds_read_b128 v[96:99], v10 offset:0
    ds_read_b128 v[100:103], v10 offset:16
    ds_read_b128 v[104:107], v10 offset:8448
    ds_read_b128 v[108:111], v10 offset:8464
    ds_read_b128 v[112:115], v10 offset:16896
    ds_read_b128 v[116:119], v10 offset:16912
    ds_read_b128 v[120:123], v10 offset:25344
    ds_read_b128 v[124:127], v10 offset:25360
    s_waitcnt lgkmcnt(6)
    v_fma_f32 v64, v96, v20, v2
    v_fma_f32 v65, v97, v20, v3
    v_fma_f32 v66, v98, v20, v4
    v_fma_f32 v67, v99, v20, v5
    v_fma_f32 v68, v100, v20, v11
    v_fma_f32 v69, v101, v20, v25
    v_fma_f32 v70, v102, v20, v29
    v_fma_f32 v71, v103, v20, v30
    s_waitcnt lgkmcnt(4)
    v_fma_f32 v64, v104, v21, v64
    v_fma_f32 v65, v105, v21, v65
    v_fma_f32 v66, v106, v21, v66
    v_fma_f32 v67, v107, v21, v67
    v_fma_f32 v68, v108, v21, v68
    v_fma_f32 v69, v109, v21, v69
    v_fma_f32 v70, v110, v21, v70
    v_fma_f32 v71, v111, v21, v71
    s_waitcnt lgkmcnt(2)
    v_fma_f32 v64, v112, v22, v64
    v_fma_f32 v65, v113, v22, v65
    v_fma_f32 v66, v114, v22, v66
    v_fma_f32 v67, v115, v22, v67
    v_fma_f32 v68, v116, v22, v68
    v_fma_f32 v69, v117, v22, v69
    v_fma_f32 v70, v118, v22, v70
    v_fma_f32 v71, v119, v22, v71
    s_waitcnt lgkmcnt(0)
    v_fma_f32 v64, v120, v23, v64
    v_fma_f32 v65, v121, v23, v65
    v_fma_f32 v66, v122, v23, v66
    v_fma_f32 v67, v123, v23, v67
    v_fma_f32 v68, v124, v23, v68
    v_fma_f32 v69, v125, v23, v69
    v_fma_f32 v70, v126, v23, v70
    v_fma_f32 v71, v127, v23, v71
    v_cvt_pk_bf16_f32 v16, v64, v65
    v_cvt_pk_bf16_f32 v17, v66, v67
    v_cvt_pk_bf16_f32 v18, v68, v69
    v_cvt_pk_bf16_f32 v19, v70, v71
    s_cbranch_scc1 L_end
    buffer_store_dwordx4 v[16:19], v6, s[32:35], 0 offen
L_end:
    s_endpgm
L_tree0:
    s_lshr_b32 s47, s3, 5
    s_lshl_b32 s47, s47, 9
    s_mov_b32 s58, 512
    s_mov_b32 s59, 0x00020000
    s_add_u32 s56, s14, s47
    s_addc_u32 s57, s15, 0
    v_lshlrev_b32 v6, 5, v29
    v_lshl_add_u32 v6, v30, 3, v6
    buffer_load_dwordx2 v[16:17], v6, s[56:59], 0 offen
    s_mov_b64 s[6:7], s[10:11]
    s_mov_b64 s[8:9], s[12:13]
    s_mov_b32 s47, s48
    s_mov_b32 s22, 4096
    s_mov_b32 s49, 1
    v_mov_b32 v7, 0
    s_lshr_b32 s51, s2, 3
    s_mul_i32 s51, s51, 4352
    v_mov_b32 v6, s51
    s_mov_b32 s51, 0x5028965f
    v_mov_b32 v76, 0xff800000
    v_mov_b32 v77, 0xff800000
    v_mov_b32 v78, 0xff800000
    v_mov_b32 v79, 0xff800000
    s_barrier
    s_and_b32 s60, s2, 7
    s_cbranch_scc1 L_noclr
    global_store_dword v6, v7, s[26:27] sc0 sc1
L_noclr:
    s_waitcnt vmcnt(0)
    v_lshlrev_b32 v72, 16, v16
    v_and_b32 v73, 0xffff0000, v16
    v_lshlrev_b32 v74, 16, v17
    v_and_b32 v75, 0xffff0000, v17
    s_add_u32 m0, s50, 0
    v_fma_f32 v72, v72, s51, -s51
    v_fma_f32 v73, v73, s51, -s51
    v_fma_f32 v74, v74, s51, -s51
    v_fma_f32 v75, v75, s51, -s51
    s_branch L_go
L_once:
    v_lshrrev_b32 v6, 2, v29
    v_mul_u32_u24 v12, 1152, v30
    v_lshl_add_u32 v12, v6, 8, v12
    v_and_b32 v7, 3, v29
    v_lshl_add_u32 v12, v7, 3, v12
    v_lshl_add_u32 v12, v6, 5, v12
    s_lshl_b32 s47, s49, 16
    s_and_b32 s47, s47, 65536
    s_add_u32 s51, s51, s47
    v_add_u32 v12, s51, v12
    v_xor_b32 v13, 32, v12
    v_xor_b32 v14, 64, v12
    v_xor_b32 v15, 96, v12
    s_lshl_b32 s47, s40, 3
    s_add_u32 s47, s47, 46080
    v_lshl_add_u32 v11, v29, 6, s47
    s_mul_i32 s47, s40, 8448
    s_add_u32 s47, s47, 111616
    v_mul_u32_u24 v9, 528, v29
    v_lshl_add_u32 v9, v30, 4, v9
    v_add_u32 v9, s47, v9
    v_lshrrev_b32 v6, 4, v0
    v_mul_u32_u24 v10, 528, v6
    v_lshl_add_u32 v10, v29, 5, v10
    v_add_u32 v10, 111616, v10
    s_branch L_onceb
L_gr0:
    s_mov_b32 s52, 1
    s_atomic_add s52, s[26:27], 0x0 glc
    v_lshl_add_u32 v6, v28, 6, 32
    s_waitcnt lgkmcnt(0)
    s_min_u32 s52, s52, 7
    s_mul_i32 s52, s52, 3
    s_sub_u32 s52, 31, s52
    s_xor_b32 s52, s52, 20
    v_mov_b32 v7, s52
    buffer_store_byte v7, v6, s[36:39], 0 offen
    s_branch L_grb0
L_gr1:
    s_mov_b32 s52, 1
    s_atomic_add s52, s[26:27], 0x0 glc
    v_lshl_add_u32 v6, v28, 6, 32
    s_waitcnt lgkmcnt(0)
    s_min_u32 s52, s52, 7
    s_mul_i32 s52, s52, 3
    s_sub_u32 s52, 31, s52
    s_xor_b32 s52, s52, 20
    v_mov_b32 v7, s52
    buffer_store_byte v7, v6, s[36:39], 0 offen
    s_branch L_grb1
.section .rodata,"a"
.p2align 6
.amdhsa_kernel standalone__tree_speculative_verify_tree_attention_over_candidate_token_tree__sampling_kernel
  .amdhsa_next_free_vgpr 256
  .amdhsa_next_free_sgpr 64
  .amdhsa_accum_offset 256
  .amdhsa_group_segment_fixed_size 0
  .amdhsa_kernarg_size 72
  .amdhsa_user_sgpr_count 2
  .amdhsa_user_sgpr_kernarg_segment_ptr 1
  .amdhsa_system_sgpr_workgroup_id_x 1
.end_amdhsa_kernel
```
